```python
import torch

def _softmax(x, axis=-1):
    return torch.softmax(x, dim=axis)

def _gelu(x):
    return torch.nn.functional.gelu(x, approximate='tanh')

def _silu(x):
    return torch.nn.functional.silu(x)

def _sigmoid(x):
    return torch.sigmoid(x)

def _layernorm(x, axis=-1, eps=1e-05):
    m = x.mean(dim=axis, keepdim=True)
    v = x.var(dim=axis, keepdim=True, unbiased=False)
    return (x - m) / torch.sqrt(v + eps)

def _scatter_add(tgt, idx, src, axis=0):
    return tgt.clone().index_add_(axis, idx, src)

def _segment_sum(src, seg, n):
    out = torch.zeros((n,) + src.shape[1:], dtype=src.dtype)
    return out.index_add_(0, seg, src)

def _pad(x, pw):
    flat = tuple((v for pair in reversed(pw) for v in pair))
    return torch.nn.functional.pad(x, flat)
kernel_name = 'standalone__tree_speculative_verify_tree_attention_over_candidate_token_tree__sampling'

def setup_inputs():

    _w = lambda a: (lambda t: t.to(torch.bfloat16) if t.is_floating_point() else t)(torch.as_tensor(a))
    B, Hq, Hkv, T, C, D = (16, 32, 8, 1, 4096, 128)
    tree_mask = torch.zeros((B, T, T), dtype=float)
    for b in range(B):
        parent = torch.zeros(T, dtype=torch.int64)
        for i in range(1, T):
            parent[i] = int(torch.randint(0, i, (1,)).item())
        for i in range(T):
            j = i
            tree_mask[b, i, j] = 1.0
            while j > 0:
                j = parent[j]
                tree_mask[b, i, j] = 1.0
    return {'q': _w((lambda *s: torch.randn(*s, dtype=torch.bfloat16) * 0.8)(B, Hq, T, D)), 'k_cache': _w((lambda *s: torch.randn(*s, dtype=torch.bfloat16) * 0.8)(B, Hkv, C, D)), 'v_cache': _w((lambda *s: torch.randn(*s, dtype=torch.bfloat16) * 0.05)(B, Hkv, C, D)), 'k_tree': _w((lambda *s: torch.randn(*s, dtype=torch.bfloat16) * 0.8)(B, Hkv, T, D)), 'v_tree': _w((lambda *s: torch.randn(*s, dtype=torch.bfloat16) * 0.05)(B, Hkv, T, D)), 'tree_mask': _w(tree_mask)}

def reference(q, k_cache, v_cache, k_tree, v_tree, tree_mask):
    B, Hq, T, D = q.shape
    Hkv, C = (k_cache.shape[1], k_cache.shape[2])
    rep = Hq // Hkv
    kc = (lambda x, n, axis: torch.repeat_interleave(x, n, dim=axis))(k_cache, rep, axis=1)
    vc = (lambda x, n, axis: torch.repeat_interleave(x, n, dim=axis))(v_cache, rep, axis=1)
    kt = (lambda x, n, axis: torch.repeat_interleave(x, n, dim=axis))(k_tree, rep, axis=1)
    vt = (lambda x, n, axis: torch.repeat_interleave(x, n, dim=axis))(v_tree, rep, axis=1)
    k = torch.concatenate([kc, kt], axis=2)
    v = torch.concatenate([vc, vt], axis=2)
    scale = D ** (-0.5)
    scores = torch.einsum('bhqd,bhkd->bhqk', q, k) * scale
    ctx_mask = torch.ones((B, 1, T, C), dtype=scores.dtype)
    tm = tree_mask[:, None, :, :].clone()
    full_mask = torch.concatenate([ctx_mask, tm], axis=-1)
    scores = scores + (1.0 - full_mask) * -1000000000.0
    p = _softmax(scores, axis=-1)
    return torch.einsum('bhqk,bhkd->bhqd', p, v)
```

```asm
; @launch grid=(256,1,1) block=(320,1,1) lds=47744
.amdgcn_target "amdgcn-amd-amdhsa--gfx950"
.text
.globl standalone__tree_speculative_verify_tree_attention_over_candidate_token_tree__sampling_kernel
.p2align 8
.type standalone__tree_speculative_verify_tree_attention_over_candidate_token_tree__sampling_kernel,@function
standalone__tree_speculative_verify_tree_attention_over_candidate_token_tree__sampling_kernel:
    s_load_dwordx16 s[4:19], s[0:1], 0
    s_cmp_ge_u32 s2, 256
    s_cbranch_scc1 L_end
    s_load_dwordx2 s[20:21], s[0:1], 64
    v_lshrrev_b32 v7, 6, v0
    v_and_b32 v11, 63, v0
    v_readfirstlane_b32 s42, v7
    s_and_b32 s40, s2, 0x3e
    s_lshl_b32 s40, s40, 1
    s_and_b32 s47, s2, 1
    s_or_b32 s40, s40, s47
    s_bfe_u32 s47, s2, 0x10006
    s_lshl1_add_u32 s40, s47, s40
    s_lshr_b32 s41, s2, 7
    v_lshlrev_b32 v2, 4, v11
    s_mov_b32 s34, 0x20000
    s_mov_b32 s35, 0x20000
    s_cmp_eq_u32 s42, 4
    s_cbranch_scc1 L_helper
    s_lshl_b32 s44, s40, 20
    s_lshl_b32 s47, s41, 14
    s_or_b32 s44, s44, s47
    s_and_b32 s47, s42, 1
    s_lshl_b32 s47, s47, 12
    s_lshr_b32 s48, s42, 1
    s_lshl_b32 s48, s48, 13
    s_or_b32 s47, s47, s48
    s_or_b32 s44, s47, s44
    v_and_b32 v7, 15, v11
    v_and_b32 v8, 48, v11
    v_lshl_add_u32 v1, v7, 6, v8
    s_mov_b32 s26, 0x8000000
    s_mov_b32 s27, 0x20000
    s_lshl_b32 s47, s40, 10
    s_waitcnt lgkmcnt(0)
    s_mov_b32 s24, s6
    s_mov_b32 s25, s7
    buffer_load_dwordx4 v[60:63], v1, s[24:27], s44 offen offset:0 nt
    s_mov_b32 s32, s4
    s_mov_b32 s33, s5
    buffer_load_dwordx4 v[12:15], v1, s[32:35], s47 offen offset:0
    buffer_load_dwordx4 v[64:67], v1, s[24:27], s44 offen offset:1024 nt
    buffer_load_dwordx4 v[68:71], v1, s[24:27], s44 offen offset:2048 nt
    buffer_load_dwordx4 v[72:75], v1, s[24:27], s44 offen offset:3072 nt
    s_xor_b32 s45, s44, 0xa000
    buffer_load_dwordx4 v[76:79], v1, s[24:27], s45 offen offset:0 nt
    v_and_b32 v3, 1, v11
    v_bfe_u32 v7, v11, 2, 2
    v_bfe_u32 v9, v11, 1, 1
    s_mov_b32 s57, s44
    s_mov_b32 s58, 0
    s_mov_b32 s28, s8
    s_mov_b32 s29, s9
    s_mov_b32 s30, 0x8000000
    s_mov_b32 s31, 0x20000
    s_mov_b32 s38, 0x101000
    s_mov_b32 s39, 0x20000
    s_and_b32 s47, s2, 7
    s_lshl_b32 s47, s47, 8
    s_add_u32 s47, s47, 0x100000
    v_lshl_add_u32 v52, v11, 1, v9
    v_add_u32 v52, s47, v52
    s_lshr_b32 s48, s2, 3
    s_lshl2_add_u32 s47, s48, s47
    s_add_u32 s47, s47, s42
    v_lshl_add_u32 v53, v11, 24, s47
    v_mov_b32 v54, 0
    s_mov_b32 s36, s20
    s_mov_b32 s37, s21
    buffer_load_ubyte v55, v52, s[36:39], 0 offen nt
    buffer_store_byte v54, v53, s[36:39], 0 offen
    s_getreg_b32 s47, hwreg(HW_REG_XCC_ID, 0, 1)
    s_cmp_eq_u32 s47, 0
    s_cselect_b32 s22, 48, 59
    v_lshrrev_b32 v56, 2, v11
    v_lshlrev_b32 v56, 4, v56
    s_lshl_b32 s47, s42, 13
    s_add_u32 s47, s47, 12928
    s_lshl_b32 s48, s42, 9
    s_add_u32 s48, s48, 45696
    v_mov_b32 v8, s47
    v_mov_b32 v4, s48
    v_and_b32 v57, 3, v11
    v_cmp_eq_u32 vcc, 0, v57
    v_mov_b32 v57, 0x200
    s_nop 0
    v_cndmask_b32 v8, v4, v8, vcc
    v_add_u32 v56, v56, v8
    v_cndmask_b32 v57, 0, v57, vcc
    v_lshlrev_b32 v3, 4, v3
    v_mov_b32 v4, 0xffff
    v_lshlrev_b32 v8, v3, v4
    v_cmp_eq_u32 vcc, 0, v9
    s_nop 1
    v_cndmask_b32 v3, 0, v8, vcc
    v_xor_b32 v4, v3, v8
    s_mul_i32 s47, s42, 2432
    v_mul_u32_u24 v48, 608, v7
    v_lshrrev_b32 v8, 4, v11
    v_mul_u32_u24 v50, 144, v8
    v_and_b32 v8, 3, v11
    v_lshl_add_u32 v8, v8, 2, s47
    v_add3_u32 v48, v48, v50, v8
    v_and_b32 v8, 15, v11
    s_lshl_b32 s47, s42, 7
    v_lshl_add_u32 v49, v8, 3, s47
    s_mul_i32 s47, s42, 608
    v_lshl_add_u32 v8, v8, 3, s47
    v_add_u32 v50, v50, v8
    s_lshl_b32 s47, s42, 5
    v_mov_b32 v51, s47
    v_mov_b32 v5, 0xff800000
    v_mov_b32 v6, 0
    s_mov_b32 s43, 0x3e0293ee
    s_mov_b64 vcc, 0
    s_mov_b64 s[52:53], -1
    v_mov_b32 v54, 1
    s_waitcnt vmcnt(7)
    buffer_load_dwordx4 v[80:83], v1, s[24:27], s45 offen offset:1024 nt
    s_waitcnt vmcnt(6)
    buffer_load_dwordx4 v[84:87], v1, s[24:27], s45 offen offset:2048 nt
    v_mfma_f32_16x16x32_bf16 v[20:23], v[60:63], v[12:15], 0
    s_waitcnt vmcnt(6)
    buffer_load_dwordx4 v[88:91], v1, s[24:27], s45 offen offset:3072 nt
    s_add_u32 s58, s58, 0x10000
    s_xor_b32 s44, s58, s57
    v_mfma_f32_16x16x32_bf16 v[24:27], v[64:67], v[12:15], 0
    s_nop 2
    v_add_f32_dpp v7, v21, v20 quad_perm:[1,1,1,1] row_mask:0xf bank_mask:0xf
    v_add_f32_dpp v8, v23, v22 quad_perm:[3,3,3,3] row_mask:0xf bank_mask:0xf
    s_nop 1
    v_add_f32_dpp v28, v8, v7 quad_perm:[2,2,2,2] row_mask:0xf bank_mask:0xf
    s_waitcnt vmcnt(6)
    buffer_load_dwordx4 v[60:63], v1, s[24:27], s44 offen offset:0 nt
    v_mfma_f32_16x16x32_bf16 v[20:23], v[68:71], v[12:15], 0
    v_add_f32_dpp v7, v25, v24 quad_perm:[1,1,1,1] row_mask:0xf bank_mask:0xf
    v_add_f32_dpp v8, v27, v26 quad_perm:[3,3,3,3] row_mask:0xf bank_mask:0xf
    s_nop 1
    v_add_f32_dpp v29, v8, v7 quad_perm:[2,2,2,2] row_mask:0xf bank_mask:0xf
    v_max3_f32 v5, v28, v29, v5
    s_waitcnt vmcnt(6)
    buffer_load_dwordx4 v[64:67], v1, s[24:27], s44 offen offset:1024 nt
    v_mfma_f32_16x16x32_bf16 v[24:27], v[72:75], v[12:15], 0
    v_add_f32_dpp v7, v21, v20 quad_perm:[1,1,1,1] row_mask:0xf bank_mask:0xf
    v_add_f32_dpp v8, v23, v22 quad_perm:[3,3,3,3] row_mask:0xf bank_mask:0xf
    s_nop 1
    v_add_f32_dpp v30, v8, v7 quad_perm:[2,2,2,2] row_mask:0xf bank_mask:0xf
    s_waitcnt vmcnt(4)
    buffer_load_dwordx4 v[68:71], v1, s[24:27], s44 offen offset:2048 nt
    v_mfma_f32_16x16x32_bf16 v[20:23], v[76:79], v[12:15], 0
    v_add_f32_dpp v7, v25, v24 quad_perm:[1,1,1,1] row_mask:0xf bank_mask:0xf
    v_add_f32_dpp v8, v27, v26 quad_perm:[3,3,3,3] row_mask:0xf bank_mask:0xf
    s_nop 1
    v_add_f32_dpp v31, v8, v7 quad_perm:[2,2,2,2] row_mask:0xf bank_mask:0xf
    v_max3_f32 v5, v30, v31, v5
    ds_write_b128 v56, v[28:31] offset:0
    s_waitcnt vmcnt(4)
    buffer_load_dwordx4 v[72:75], v1, s[24:27], s44 offen offset:3072 nt
    s_xor_b32 s45, s44, 0xa000
    v_mfma_f32_16x16x32_bf16 v[24:27], v[80:83], v[12:15], 0
    v_add_f32_dpp v7, v21, v20 quad_perm:[1,1,1,1] row_mask:0xf bank_mask:0xf
    v_add_f32_dpp v8, v23, v22 quad_perm:[3,3,3,3] row_mask:0xf bank_mask:0xf
    s_nop 1
    v_add_f32_dpp v28, v8, v7 quad_perm:[2,2,2,2] row_mask:0xf bank_mask:0xf
    s_waitcnt vmcnt(4)
    buffer_load_dwordx4 v[76:79], v1, s[24:27], s45 offen offset:0 nt
    v_mfma_f32_16x16x32_bf16 v[20:23], v[84:87], v[12:15], 0
    v_add_f32_dpp v7, v25, v24 quad_perm:[1,1,1,1] row_mask:0xf bank_mask:0xf
    v_add_f32_dpp v8, v27, v26 quad_perm:[3,3,3,3] row_mask:0xf bank_mask:0xf
    s_nop 1
    v_add_f32_dpp v29, v8, v7 quad_perm:[2,2,2,2] row_mask:0xf bank_mask:0xf
    v_max3_f32 v5, v28, v29, v5
    s_waitcnt vmcnt(4)
    buffer_load_dwordx4 v[80:83], v1, s[24:27], s45 offen offset:1024 nt
    v_mfma_f32_16x16x32_bf16 v[24:27], v[88:91], v[12:15], 0
    v_add_f32_dpp v7, v21, v20 quad_perm:[1,1,1,1] row_mask:0xf bank_mask:0xf
    v_add_f32_dpp v8, v23, v22 quad_perm:[3,3,3,3] row_mask:0xf bank_mask:0xf
    s_nop 1
    v_add_f32_dpp v30, v8, v7 quad_perm:[2,2,2,2] row_mask:0xf bank_mask:0xf
    s_mov_b32 s46, 14
L_kloop:
    buffer_load_ubyte v55, v52, s[36:39], 0 offen nt
    buffer_store_byte v54, v53, s[36:39], 0 offen
    s_cbranch_vccnz L_w1
    s_waitcnt vmcnt(6)
L_w1:
    s_waitcnt vmcnt(7)
    buffer_load_dwordx4 v[84:87], v1, s[24:27], s45 offen offset:2048 nt
    v_mfma_f32_16x16x32_bf16 v[20:23], v[60:63], v[12:15], 0
    v_add_f32_dpp v7, v25, v24 quad_perm:[1,1,1,1] row_mask:0xf bank_mask:0xf
    v_add_f32_dpp v8, v27, v26 quad_perm:[3,3,3,3] row_mask:0xf bank_mask:0xf
    s_nop 1
    v_add_f32_dpp v31, v8, v7 quad_perm:[2,2,2,2] row_mask:0xf bank_mask:0xf
    v_max3_f32 v5, v30, v31, v5
    ds_write_b128 v56, v[28:31] offset:256
    v_add_u32 v56, v57, v56
    s_cbranch_vccnz L_w2
    s_waitcnt vmcnt(6)
L_w2:
    s_waitcnt vmcnt(7)
    buffer_load_dwordx4 v[88:91], v1, s[24:27], s45 offen offset:3072 nt
    s_add_u32 s58, s58, 0x10000
    s_xor_b32 s44, s58, s57
    v_mfma_f32_16x16x32_bf16 v[24:27], v[64:67], v[12:15], 0
    v_add_f32_dpp v7, v21, v20 quad_perm:[1,1,1,1] row_mask:0xf bank_mask:0xf
    v_add_f32_dpp v8, v23, v22 quad_perm:[3,3,3,3] row_mask:0xf bank_mask:0xf
    s_nop 1
    v_add_f32_dpp v28, v8, v7 quad_perm:[2,2,2,2] row_mask:0xf bank_mask:0xf
    s_cbranch_vccnz L_w3
    s_waitcnt vmcnt(6)
L_w3:
    s_waitcnt vmcnt(7)
    buffer_load_dwordx4 v[60:63], v1, s[24:27], s44 offen offset:0 nt
    v_mfma_f32_16x16x32_bf16 v[20:23], v[68:71], v[12:15], 0
    v_add_f32_dpp v7, v25, v24 quad_perm:[1,1,1,1] row_mask:0xf bank_mask:0xf
    v_add_f32_dpp v8, v27, v26 quad_perm:[3,3,3,3] row_mask:0xf bank_mask:0xf
    s_nop 1
    v_add_f32_dpp v29, v8, v7 quad_perm:[2,2,2,2] row_mask:0xf bank_mask:0xf
    v_max3_f32 v5, v28, v29, v5
    s_cbranch_vccnz L_w4
    s_waitcnt vmcnt(6)
L_w4:
    s_waitcnt vmcnt(7)
    buffer_load_dwordx4 v[64:67], v1, s[24:27], s44 offen offset:1024 nt
    v_mfma_f32_16x16x32_bf16 v[24:27], v[72:75], v[12:15], 0
    v_add_f32_dpp v7, v21, v20 quad_perm:[1,1,1,1] row_mask:0xf bank_mask:0xf
    v_add_f32_dpp v8, v23, v22 quad_perm:[3,3,3,3] row_mask:0xf bank_mask:0xf
    s_nop 1
    v_add_f32_dpp v30, v8, v7 quad_perm:[2,2,2,2] row_mask:0xf bank_mask:0xf
    s_cbranch_vccnz L_w5
    s_waitcnt vmcnt(6)
L_w5:
    s_waitcnt vmcnt(7)
    buffer_load_dwordx4 v[68:71], v1, s[24:27], s44 offen offset:2048 nt
    v_mfma_f32_16x16x32_bf16 v[20:23], v[76:79], v[12:15], 0
    v_add_f32_dpp v7, v25, v24 quad_perm:[1,1,1,1] row_mask:0xf bank_mask:0xf
    v_add_f32_dpp v8, v27, v26 quad_perm:[3,3,3,3] row_mask:0xf bank_mask:0xf
    s_nop 1
    v_add_f32_dpp v31, v8, v7 quad_perm:[2,2,2,2] row_mask:0xf bank_mask:0xf
    v_max3_f32 v5, v30, v31, v5
    ds_write_b128 v56, v[28:31] offset:0
    s_cbranch_vccnz L_w6
    s_waitcnt vmcnt(4)
L_w6:
    s_waitcnt vmcnt(7)
    buffer_load_dwordx4 v[72:75], v1, s[24:27], s44 offen offset:3072 nt
    s_xor_b32 s45, s44, 0xa000
    v_mfma_f32_16x16x32_bf16 v[24:27], v[80:83], v[12:15], 0
    v_add_f32_dpp v7, v21, v20 quad_perm:[1,1,1,1] row_mask:0xf bank_mask:0xf
    v_add_f32_dpp v8, v23, v22 quad_perm:[3,3,3,3] row_mask:0xf bank_mask:0xf
    s_nop 1
    v_add_f32_dpp v28, v8, v7 quad_perm:[2,2,2,2] row_mask:0xf bank_mask:0xf
    s_cbranch_vccnz L_w7
    s_waitcnt vmcnt(4)
L_w7:
    s_waitcnt vmcnt(5)
    buffer_load_dwordx4 v[76:79], v1, s[24:27], s45 offen offset:0 nt
    v_mfma_f32_16x16x32_bf16 v[20:23], v[84:87], v[12:15], 0
    v_add_f32_dpp v7, v25, v24 quad_perm:[1,1,1,1] row_mask:0xf bank_mask:0xf
    v_add_f32_dpp v8, v27, v26 quad_perm:[3,3,3,3] row_mask:0xf bank_mask:0xf
    s_nop 1
    v_add_f32_dpp v29, v8, v7 quad_perm:[2,2,2,2] row_mask:0xf bank_mask:0xf
    v_max3_f32 v5, v28, v29, v5
    s_cbranch_vccnz L_w8
    s_waitcnt vmcnt(4)
L_w8:
    s_waitcnt vmcnt(5)
    buffer_load_dwordx4 v[80:83], v1, s[24:27], s45 offen offset:1024 nt
    v_mfma_f32_16x16x32_bf16 v[24:27], v[88:91], v[12:15], 0
    v_add_f32_dpp v7, v21, v20 quad_perm:[1,1,1,1] row_mask:0xf bank_mask:0xf
    v_add_f32_dpp v8, v23, v22 quad_perm:[3,3,3,3] row_mask:0xf bank_mask:0xf
    s_nop 1
    v_add_f32_dpp v30, v8, v7 quad_perm:[2,2,2,2] row_mask:0xf bank_mask:0xf
    v_sub_u32 v55, v55, v54
    v_add_u32 v54, 1, v54
    v_cmp_gt_i32 s[54:55], 4, v55
    v_cmp_gt_u32 s[50:51], 4, v55
    s_nop 0
    s_and_b64 s[52:53], s[52:53], s[54:55]
    s_and_b64 s[50:51], s[50:51], s[52:53]
    s_bcnt1_i32_b64 s23, s[50:51]
    s_cmp_ge_u32 s23, s22
    s_cselect_b64 vcc, -1, 0
    s_sub_u32 s46, s46, 1
    s_cmp_lg_u32 s46, 0
    s_cbranch_scc1 L_kloop
L_touch0:
    s_cbranch_execz L_touch1
    buffer_load_ubyte v55, v52, s[36:39], 0 offen nt
L_touch1:
    s_cbranch_execz L_touch2
    buffer_store_byte v54, v53, s[36:39], 0 offen
    s_cbranch_vccnz L_w9
    s_waitcnt vmcnt(6)
L_w9:
    s_waitcnt vmcnt(7)
    buffer_load_dwordx4 v[84:87], v1, s[24:27], s45 offen offset:2048 nt
    v_mfma_f32_16x16x32_bf16 v[20:23], v[60:63], v[12:15], 0
    v_add_f32_dpp v7, v25, v24 quad_perm:[1,1,1,1] row_mask:0xf bank_mask:0xf
    v_add_f32_dpp v8, v27, v26 quad_perm:[3,3,3,3] row_mask:0xf bank_mask:0xf
    s_nop 1
L_touch2:
    s_cbranch_execz L_touch3
    v_add_f32_dpp v31, v8, v7 quad_perm:[2,2,2,2] row_mask:0xf bank_mask:0xf
    v_max3_f32 v5, v30, v31, v5
    ds_write_b128 v56, v[28:31] offset:256
    v_add_u32 v56, v57, v56
    s_cbranch_vccnz L_w10
    s_waitcnt vmcnt(6)
L_w10:
    s_waitcnt vmcnt(7)
    buffer_load_dwordx4 v[88:91], v1, s[24:27], s45 offen offset:3072 nt
    s_mov_b32 s58, 0
    s_mov_b32 s44, s57
    v_mfma_f32_16x16x32_bf16 v[24:27], v[64:67], v[12:15], 0
L_touch3:
    s_cbranch_execz L_touch4
    v_add_f32_dpp v7, v21, v20 quad_perm:[1,1,1,1] row_mask:0xf bank_mask:0xf
    v_add_f32_dpp v8, v23, v22 quad_perm:[3,3,3,3] row_mask:0xf bank_mask:0xf
    s_nop 1
    v_add_f32_dpp v28, v8, v7 quad_perm:[2,2,2,2] row_mask:0xf bank_mask:0xf
    s_cbranch_vccnz L_w11
    s_waitcnt vmcnt(6)
L_w11:
    s_waitcnt vmcnt(7)
    buffer_load_dwordx4 v[92:95], v2, s[28:31], s44 offen offset:0 nt
    v_mfma_f32_16x16x32_bf16 v[20:23], v[68:71], v[12:15], 0
L_touch4:
    s_cbranch_execz L_touch5
    v_add_f32_dpp v7, v25, v24 quad_perm:[1,1,1,1] row_mask:0xf bank_mask:0xf
    v_add_f32_dpp v8, v27, v26 quad_perm:[3,3,3,3] row_mask:0xf bank_mask:0xf
    s_nop 1
    v_add_f32_dpp v29, v8, v7 quad_perm:[2,2,2,2] row_mask:0xf bank_mask:0xf
    v_max3_f32 v5, v28, v29, v5
    s_cbranch_vccnz L_w12
    s_waitcnt vmcnt(6)
L_w12:
    s_waitcnt vmcnt(7)
    buffer_load_dwordx4 v[96:99], v2, s[28:31], s44 offen offset:1024 nt
    v_mfma_f32_16x16x32_bf16 v[24:27], v[72:75], v[12:15], 0
L_touch5:
    s_cbranch_execz L_touch6
    v_add_f32_dpp v7, v21, v20 quad_perm:[1,1,1,1] row_mask:0xf bank_mask:0xf
    v_add_f32_dpp v8, v23, v22 quad_perm:[3,3,3,3] row_mask:0xf bank_mask:0xf
    s_nop 1
    v_add_f32_dpp v30, v8, v7 quad_perm:[2,2,2,2] row_mask:0xf bank_mask:0xf
    s_cbranch_vccnz L_w13
    s_waitcnt vmcnt(6)
L_w13:
    s_waitcnt vmcnt(7)
    buffer_load_dwordx4 v[100:103], v2, s[28:31], s44 offen offset:2048 nt
    v_mfma_f32_16x16x32_bf16 v[20:23], v[76:79], v[12:15], 0
L_touch6:
    s_cbranch_execz L_touch7
    v_add_f32_dpp v7, v25, v24 quad_perm:[1,1,1,1] row_mask:0xf bank_mask:0xf
    v_add_f32_dpp v8, v27, v26 quad_perm:[3,3,3,3] row_mask:0xf bank_mask:0xf
    s_nop 1
    v_add_f32_dpp v31, v8, v7 quad_perm:[2,2,2,2] row_mask:0xf bank_mask:0xf
    v_max3_f32 v5, v30, v31, v5
    ds_write_b128 v56, v[28:31] offset:0
    s_cbranch_vccnz L_w14
    s_waitcnt vmcnt(4)
L_w14:
    s_waitcnt vmcnt(7)
    buffer_load_dwordx4 v[104:107], v2, s[28:31], s44 offen offset:3072 nt
L_touch7:
    s_cbranch_execz L_touch8
    s_xor_b32 s45, s44, 0xa000
    v_mfma_f32_16x16x32_bf16 v[24:27], v[80:83], v[12:15], 0
    v_add_f32_dpp v7, v21, v20 quad_perm:[1,1,1,1] row_mask:0xf bank_mask:0xf
    v_add_f32_dpp v8, v23, v22 quad_perm:[3,3,3,3] row_mask:0xf bank_mask:0xf
    s_nop 1
    v_add_f32_dpp v28, v8, v7 quad_perm:[2,2,2,2] row_mask:0xf bank_mask:0xf
    s_cbranch_vccnz L_w15
    s_waitcnt vmcnt(4)
L_w15:
    s_waitcnt vmcnt(5)
L_touch8:
    s_cbranch_execz L_touch9
    buffer_load_dwordx4 v[108:111], v2, s[28:31], s45 offen offset:0 nt
    v_mfma_f32_16x16x32_bf16 v[20:23], v[84:87], v[12:15], 0
    v_add_f32_dpp v7, v25, v24 quad_perm:[1,1,1,1] row_mask:0xf bank_mask:0xf
    v_add_f32_dpp v8, v27, v26 quad_perm:[3,3,3,3] row_mask:0xf bank_mask:0xf
    s_nop 1
    v_add_f32_dpp v29, v8, v7 quad_perm:[2,2,2,2] row_mask:0xf bank_mask:0xf
    v_max3_f32 v5, v28, v29, v5
    s_cbranch_vccnz L_w16
    s_waitcnt vmcnt(4)
L_w16:
L_touch9:
    s_cbranch_execz L_touch10
    s_waitcnt vmcnt(5)
    buffer_load_dwordx4 v[112:115], v2, s[28:31], s45 offen offset:1024 nt
    v_mfma_f32_16x16x32_bf16 v[24:27], v[88:91], v[12:15], 0
    v_add_f32_dpp v7, v21, v20 quad_perm:[1,1,1,1] row_mask:0xf bank_mask:0xf
    v_add_f32_dpp v8, v23, v22 quad_perm:[3,3,3,3] row_mask:0xf bank_mask:0xf
    s_nop 1
    v_add_f32_dpp v30, v8, v7 quad_perm:[2,2,2,2] row_mask:0xf bank_mask:0xf
    v_sub_u32 v55, v55, v54
    v_add_u32 v54, 1, v54
    v_cmp_gt_i32 s[54:55], 4, v55
L_touch10:
    s_cbranch_execz L_touch11
    v_cmp_gt_u32 s[50:51], 4, v55
    s_nop 0
    s_and_b64 s[52:53], s[52:53], s[54:55]
    s_and_b64 s[50:51], s[50:51], s[52:53]
    s_bcnt1_i32_b64 s23, s[50:51]
    s_cmp_ge_u32 s23, s22
    s_cselect_b64 vcc, -1, 0
    buffer_load_ubyte v55, v52, s[36:39], 0 offen nt
    buffer_store_byte v54, v53, s[36:39], 0 offen
    s_cbranch_vccnz L_w17
    s_waitcnt vmcnt(6)
L_w17:
L_touch11:
    s_cbranch_execz L_touch12
    s_waitcnt vmcnt(7)
    buffer_load_dwordx4 v[116:119], v2, s[28:31], s45 offen offset:2048 nt
    v_add_f32_dpp v7, v25, v24 quad_perm:[1,1,1,1] row_mask:0xf bank_mask:0xf
    v_add_f32_dpp v8, v27, v26 quad_perm:[3,3,3,3] row_mask:0xf bank_mask:0xf
    s_nop 1
    v_add_f32_dpp v31, v8, v7 quad_perm:[2,2,2,2] row_mask:0xf bank_mask:0xf
    v_max3_f32 v5, v30, v31, v5
    ds_write_b128 v56, v[28:31] offset:256
    v_add_u32 v56, v57, v56
L_touch12:
    s_cbranch_execz L_touch13
    v_mov_b32 v8, v5
    v_lshrrev_b32 v56, 2, v11
    v_lshlrev_b32 v56, 4, v56
    v_permlane32_swap_b32 v5, v8
    s_lshl_b32 s47, s42, 13
    s_add_u32 s47, s47, 12928
    v_add_u32 v56, s47, v56
    ds_read_b128 v[28:31], v56 offset:0
    ds_read_b128 v[12:15], v56 offset:256
    v_add_u32 v56, 0x200, v56
    v_max_f32 v5, v5, v8
L_touch13:
    s_cbranch_execz L_touch14
    v_mov_b32 v8, v5
    s_nop 1
    v_permlane16_swap_b32 v5, v8
    v_max_f32 v5, v5, v8
    v_mul_f32 v5, s43, v5
    s_nop 1
    v_mov_b32_dpp v10, v5 quad_perm:[0,0,0,0] row_mask:0xf bank_mask:0xf
    s_waitcnt lgkmcnt(1)
    v_fma_f32 v28, v28, s43, -v10
    v_exp_f32 v28, v28
    s_nop 0
    v_cvt_pk_bf16_f32 v7, v28, v28
L_touch14:
    s_cbranch_execz L_touch15
    v_add_f32 v6, v6, v28
    v_and_b32 v32, v7, v3
    v_and_b32 v33, v7, v4
    v_fma_f32 v29, v29, s43, -v10
    v_exp_f32 v29, v29
    s_nop 0
    v_cvt_pk_bf16_f32 v7, v29, v29
    v_add_f32 v6, v6, v29
    v_and_b32 v34, v7, v3
    v_and_b32 v35, v7, v4
    s_cbranch_vccnz L_w18
    s_waitcnt vmcnt(6)
L_w18:
    s_waitcnt vmcnt(7)
L_touch15:
    s_cbranch_execz L_touch16
    buffer_load_dwordx4 v[120:123], v2, s[28:31], s45 offen offset:3072 nt
    s_add_u32 s58, s58, 0x10000
    s_xor_b32 s44, s58, s57
    v_fma_f32 v30, v30, s43, -v10
    v_exp_f32 v30, v30
    s_nop 0
    v_cvt_pk_bf16_f32 v7, v30, v30
    v_add_f32 v6, v6, v30
    v_and_b32 v36, v7, v3
    v_and_b32 v37, v7, v4
    v_fma_f32 v31, v31, s43, -v10
L_touch16:
    s_cbranch_execz L_touch17
    v_exp_f32 v31, v31
    s_nop 0
    v_cvt_pk_bf16_f32 v7, v31, v31
    v_add_f32 v6, v6, v31
    v_and_b32 v38, v7, v3
    v_and_b32 v39, v7, v4
    v_mfma_f32_16x16x16_bf16 v[40:43], v[92:93], v[32:33], 0
    v_mfma_f32_16x16x16_bf16 v[44:47], v[94:95], v[32:33], 0
    s_waitcnt lgkmcnt(0)
    ds_read_b128 v[28:31], v56 offset:0
L_touch17:
    s_cbranch_execz L_touch18
    v_fma_f32 v12, v12, s43, -v10
    v_exp_f32 v12, v12
    s_nop 0
    v_cvt_pk_bf16_f32 v7, v12, v12
    v_add_f32 v6, v6, v12
    v_and_b32 v32, v7, v3
    v_and_b32 v33, v7, v4
    v_mfma_f32_16x16x16_bf16 v[40:43], v[96:97], v[34:35], v[40:43]
    v_mfma_f32_16x16x16_bf16 v[44:47], v[98:99], v[34:35], v[44:47]
    v_fma_f32 v13, v13, s43, -v10
L_touch18:
    s_cbranch_execz L_touch19
    v_exp_f32 v13, v13
    s_nop 0
    v_cvt_pk_bf16_f32 v7, v13, v13
    v_add_f32 v6, v6, v13
    v_and_b32 v34, v7, v3
    v_and_b32 v35, v7, v4
    s_cbranch_vccnz L_w19
    s_waitcnt vmcnt(6)
L_w19:
    s_waitcnt vmcnt(7)
    buffer_load_dwordx4 v[92:95], v2, s[28:31], s44 offen offset:0 nt
    v_mfma_f32_16x16x16_bf16 v[40:43], v[100:101], v[36:37], v[40:43]
    v_mfma_f32_16x16x16_bf16 v[44:47], v[102:103], v[36:37], v[44:47]
L_touch19:
    s_cbranch_execz L_touch20
    v_fma_f32 v14, v14, s43, -v10
    v_exp_f32 v14, v14
    s_nop 0
    v_cvt_pk_bf16_f32 v7, v14, v14
    v_add_f32 v6, v6, v14
    v_and_b32 v36, v7, v3
    v_and_b32 v37, v7, v4
    s_cbranch_vccnz L_w20
    s_waitcnt vmcnt(6)
L_w20:
    s_waitcnt vmcnt(7)
    buffer_load_dwordx4 v[96:99], v2, s[28:31], s44 offen offset:1024 nt
L_touch20:
    s_cbranch_execz L_touch21
    v_mfma_f32_16x16x16_bf16 v[40:43], v[104:105], v[38:39], v[40:43]
    v_mfma_f32_16x16x16_bf16 v[44:47], v[106:107], v[38:39], v[44:47]
    v_fma_f32 v15, v15, s43, -v10
    v_exp_f32 v15, v15
    s_nop 0
    v_cvt_pk_bf16_f32 v7, v15, v15
    v_add_f32 v6, v6, v15
    v_and_b32 v38, v7, v3
    v_and_b32 v39, v7, v4
    s_cbranch_vccnz L_w21
    s_waitcnt vmcnt(6)
L_w21:
L_touch21:
    s_cbranch_execz L_touch22
    s_waitcnt vmcnt(7)
    buffer_load_dwordx4 v[100:103], v2, s[28:31], s44 offen offset:2048 nt
    v_mfma_f32_16x16x16_bf16 v[40:43], v[108:109], v[32:33], v[40:43]
    v_mfma_f32_16x16x16_bf16 v[44:47], v[110:111], v[32:33], v[44:47]
    s_waitcnt lgkmcnt(0)
    ds_read_b128 v[12:15], v56 offset:256
    v_add_u32 v56, 0x200, v56
    v_fma_f32 v28, v28, s43, -v10
    v_exp_f32 v28, v28
L_touch22:
    s_cbranch_execz L_touch23
    s_nop 0
    v_cvt_pk_bf16_f32 v7, v28, v28
    v_add_f32 v6, v6, v28
    v_and_b32 v32, v7, v3
    v_and_b32 v33, v7, v4
    s_cbranch_vccnz L_w22
    s_waitcnt vmcnt(4)
L_w22:
    s_waitcnt vmcnt(7)
    buffer_load_dwordx4 v[104:107], v2, s[28:31], s44 offen offset:3072 nt
    s_xor_b32 s45, s44, 0xa000
    v_mfma_f32_16x16x16_bf16 v[40:43], v[112:113], v[34:35], v[40:43]
L_touch23:
    s_cbranch_execz L_touch24
    v_mfma_f32_16x16x16_bf16 v[44:47], v[114:115], v[34:35], v[44:47]
    v_fma_f32 v29, v29, s43, -v10
    v_exp_f32 v29, v29
    s_nop 0
    v_cvt_pk_bf16_f32 v7, v29, v29
    v_add_f32 v6, v6, v29
    v_and_b32 v34, v7, v3
    v_and_b32 v35, v7, v4
    s_cbranch_vccnz L_w23
    s_waitcnt vmcnt(4)
L_w23:
    s_waitcnt vmcnt(5)
    buffer_load_dwordx4 v[108:111], v2, s[28:31], s45 offen offset:0 nt
L_touch24:
    s_cbranch_execz L_touch25
    v_mfma_f32_16x16x16_bf16 v[40:43], v[116:117], v[36:37], v[40:43]
    v_mfma_f32_16x16x16_bf16 v[44:47], v[118:119], v[36:37], v[44:47]
    v_fma_f32 v30, v30, s43, -v10
    v_exp_f32 v30, v30
    s_nop 0
    v_cvt_pk_bf16_f32 v7, v30, v30
    v_add_f32 v6, v6, v30
    v_and_b32 v36, v7, v3
    v_and_b32 v37, v7, v4
    s_cbranch_vccnz L_w24
L_touch25:
    s_cbranch_execz L_touch26
    s_waitcnt vmcnt(4)
L_w24:
    s_waitcnt vmcnt(5)
    buffer_load_dwordx4 v[112:115], v2, s[28:31], s45 offen offset:1024 nt
    v_mfma_f32_16x16x16_bf16 v[40:43], v[120:121], v[38:39], v[40:43]
    v_mfma_f32_16x16x16_bf16 v[44:47], v[122:123], v[38:39], v[44:47]
    v_fma_f32 v31, v31, s43, -v10
    v_exp_f32 v31, v31
    s_nop 0
    v_cvt_pk_bf16_f32 v7, v31, v31
    v_add_f32 v6, v6, v31
L_touch26:
    s_cbranch_execz L_touch27
    v_and_b32 v38, v7, v3
    v_and_b32 v39, v7, v4
    v_sub_u32 v55, v55, v54
    v_add_u32 v54, 1, v54
    v_cmp_gt_i32 s[54:55], 4, v55
    v_cmp_gt_u32 s[50:51], 4, v55
    s_nop 0
    s_and_b64 s[52:53], s[52:53], s[54:55]
    s_and_b64 s[50:51], s[50:51], s[52:53]
    s_bcnt1_i32_b64 s23, s[50:51]
    s_cmp_ge_u32 s23, s22
    s_cselect_b64 vcc, -1, 0
    s_mov_b32 s46, 13
L_vloop:
L_touch27:
    s_cbranch_execz L_touch28
    buffer_load_ubyte v55, v52, s[36:39], 0 offen nt
    buffer_store_byte v54, v53, s[36:39], 0 offen
    s_cbranch_vccnz L_w25
    s_waitcnt vmcnt(6)
L_w25:
    s_waitcnt vmcnt(7)
    buffer_load_dwordx4 v[116:119], v2, s[28:31], s45 offen offset:2048 nt
    v_mfma_f32_16x16x16_bf16 v[40:43], v[92:93], v[32:33], v[40:43]
    v_mfma_f32_16x16x16_bf16 v[44:47], v[94:95], v[32:33], v[44:47]
    s_waitcnt lgkmcnt(0)
    ds_read_b128 v[28:31], v56 offset:0
L_touch28:
    s_cbranch_execz L_touch29
    v_fma_f32 v12, v12, s43, -v10
    v_exp_f32 v12, v12
    s_nop 0
    v_cvt_pk_bf16_f32 v7, v12, v12
    v_add_f32 v6, v6, v12
    v_and_b32 v32, v7, v3
    v_and_b32 v33, v7, v4
    s_cbranch_vccnz L_w26
    s_waitcnt vmcnt(6)
L_w26:
    s_waitcnt vmcnt(7)
    buffer_load_dwordx4 v[120:123], v2, s[28:31], s45 offen offset:3072 nt
L_touch29:
    s_cbranch_execz L_touch30
    s_add_u32 s58, s58, 0x10000
    s_xor_b32 s44, s58, s57
    v_mfma_f32_16x16x16_bf16 v[40:43], v[96:97], v[34:35], v[40:43]
    v_mfma_f32_16x16x16_bf16 v[44:47], v[98:99], v[34:35], v[44:47]
    v_fma_f32 v13, v13, s43, -v10
    v_exp_f32 v13, v13
    s_nop 0
    v_cvt_pk_bf16_f32 v7, v13, v13
    v_add_f32 v6, v6, v13
    v_and_b32 v34, v7, v3
L_touch30:
    s_cbranch_execz L_touch31
    v_and_b32 v35, v7, v4
    s_cbranch_vccnz L_w27
    s_waitcnt vmcnt(6)
L_w27:
    s_waitcnt vmcnt(7)
    buffer_load_dwordx4 v[92:95], v2, s[28:31], s44 offen offset:0 nt
    v_mfma_f32_16x16x16_bf16 v[40:43], v[100:101], v[36:37], v[40:43]
    v_mfma_f32_16x16x16_bf16 v[44:47], v[102:103], v[36:37], v[44:47]
    v_fma_f32 v14, v14, s43, -v10
    v_exp_f32 v14, v14
    s_nop 0
    v_cvt_pk_bf16_f32 v7, v14, v14
L_touch31:
    s_cbranch_execz L_touch32
    v_add_f32 v6, v6, v14
    v_and_b32 v36, v7, v3
    v_and_b32 v37, v7, v4
    s_cbranch_vccnz L_w28
    s_waitcnt vmcnt(6)
L_w28:
    s_waitcnt vmcnt(7)
    buffer_load_dwordx4 v[96:99], v2, s[28:31], s44 offen offset:1024 nt
    v_mfma_f32_16x16x16_bf16 v[40:43], v[104:105], v[38:39], v[40:43]
    v_mfma_f32_16x16x16_bf16 v[44:47], v[106:107], v[38:39], v[44:47]
    v_fma_f32 v15, v15, s43, -v10
L_touch32:
    s_cbranch_execz L_touch33
    v_exp_f32 v15, v15
    s_nop 0
    v_cvt_pk_bf16_f32 v7, v15, v15
    v_add_f32 v6, v6, v15
    v_and_b32 v38, v7, v3
    v_and_b32 v39, v7, v4
    s_cbranch_vccnz L_w29
    s_waitcnt vmcnt(6)
L_w29:
    s_waitcnt vmcnt(7)
    buffer_load_dwordx4 v[100:103], v2, s[28:31], s44 offen offset:2048 nt
    v_mfma_f32_16x16x16_bf16 v[40:43], v[108:109], v[32:33], v[40:43]
    v_mfma_f32_16x16x16_bf16 v[44:47], v[110:111], v[32:33], v[44:47]
L_touch33:
    s_cbranch_execz L_touch34
    s_waitcnt lgkmcnt(0)
    ds_read_b128 v[12:15], v56 offset:256
    v_add_u32 v56, 0x200, v56
    v_fma_f32 v28, v28, s43, -v10
    v_exp_f32 v28, v28
    s_nop 0
    v_cvt_pk_bf16_f32 v7, v28, v28
    v_add_f32 v6, v6, v28
    v_and_b32 v32, v7, v3
    v_and_b32 v33, v7, v4
L_touch34:
    s_cbranch_execz L_touch35
    s_cbranch_vccnz L_w30
    s_waitcnt vmcnt(4)
L_w30:
    s_waitcnt vmcnt(7)
    buffer_load_dwordx4 v[104:107], v2, s[28:31], s44 offen offset:3072 nt
    s_xor_b32 s45, s44, 0xa000
    v_mfma_f32_16x16x16_bf16 v[40:43], v[112:113], v[34:35], v[40:43]
    v_mfma_f32_16x16x16_bf16 v[44:47], v[114:115], v[34:35], v[44:47]
    v_fma_f32 v29, v29, s43, -v10
    v_exp_f32 v29, v29
    s_nop 0
L_touch35:
    s_cbranch_execz L_touch36
    v_cvt_pk_bf16_f32 v7, v29, v29
    v_add_f32 v6, v6, v29
    v_and_b32 v34, v7, v3
    v_and_b32 v35, v7, v4
    s_cbranch_vccnz L_w31
    s_waitcnt vmcnt(4)
L_w31:
    s_waitcnt vmcnt(5)
    buffer_load_dwordx4 v[108:111], v2, s[28:31], s45 offen offset:0 nt
    v_mfma_f32_16x16x16_bf16 v[40:43], v[116:117], v[36:37], v[40:43]
    v_mfma_f32_16x16x16_bf16 v[44:47], v[118:119], v[36:37], v[44:47]
    v_fma_f32 v30, v30, s43, -v10
L_touch36:
    s_cbranch_execz L_touch37
    v_exp_f32 v30, v30
    s_nop 0
    v_cvt_pk_bf16_f32 v7, v30, v30
    v_add_f32 v6, v6, v30
    v_and_b32 v36, v7, v3
    v_and_b32 v37, v7, v4
    s_cbranch_vccnz L_w32
    s_waitcnt vmcnt(4)
L_w32:
    s_waitcnt vmcnt(5)
    buffer_load_dwordx4 v[112:115], v2, s[28:31], s45 offen offset:1024 nt
    v_mfma_f32_16x16x16_bf16 v[40:43], v[120:121], v[38:39], v[40:43]
L_touch37:
    s_cbranch_execz L_touch38
    v_mfma_f32_16x16x16_bf16 v[44:47], v[122:123], v[38:39], v[44:47]
    v_fma_f32 v31, v31, s43, -v10
    v_exp_f32 v31, v31
    s_nop 0
    v_cvt_pk_bf16_f32 v7, v31, v31
    v_add_f32 v6, v6, v31
    v_and_b32 v38, v7, v3
    v_and_b32 v39, v7, v4
    v_sub_u32 v55, v55, v54
    v_add_u32 v54, 1, v54
    v_cmp_gt_i32 s[54:55], 4, v55
L_touch38:
    s_cbranch_execz L_touch39
    v_cmp_gt_u32 s[50:51], 4, v55
    s_nop 0
    s_and_b64 s[52:53], s[52:53], s[54:55]
    s_and_b64 s[50:51], s[50:51], s[52:53]
    s_bcnt1_i32_b64 s23, s[50:51]
    s_cmp_ge_u32 s23, s22
    s_cselect_b64 vcc, -1, 0
    s_sub_u32 s46, s46, 1
    s_cmp_lg_u32 s46, 0
    s_cbranch_scc1 L_vloop
    s_waitcnt vmcnt(5)
    buffer_load_dwordx4 v[116:119], v2, s[28:31], s45 offen offset:2048 nt
    buffer_load_dwordx4 v[120:123], v2, s[28:31], s45 offen offset:3072 nt
L_touch39:
    s_cbranch_execz L_touch40
    s_add_u32 s58, s58, 0x10000
    s_xor_b32 s44, s58, s57
    v_mfma_f32_16x16x16_bf16 v[40:43], v[92:93], v[32:33], v[40:43]
    v_mfma_f32_16x16x16_bf16 v[44:47], v[94:95], v[32:33], v[44:47]
    s_waitcnt lgkmcnt(0)
    ds_read_b128 v[28:31], v56 offset:0
    v_fma_f32 v12, v12, s43, -v10
    v_exp_f32 v12, v12
    s_nop 0
L_touch40:
    s_cbranch_execz L_touch41
    v_cvt_pk_bf16_f32 v7, v12, v12
    v_add_f32 v6, v6, v12
    v_and_b32 v32, v7, v3
    v_and_b32 v33, v7, v4
    s_waitcnt vmcnt(6)
    buffer_load_dwordx4 v[60:63], v2, s[28:31], s44 offen offset:0 nt
    v_mfma_f32_16x16x16_bf16 v[40:43], v[96:97], v[34:35], v[40:43]
    v_mfma_f32_16x16x16_bf16 v[44:47], v[98:99], v[34:35], v[44:47]
    v_fma_f32 v13, v13, s43, -v10
    v_exp_f32 v13, v13
L_touch41:
    s_cbranch_execz L_touch42
    s_nop 0
    v_cvt_pk_bf16_f32 v7, v13, v13
    v_add_f32 v6, v6, v13
    v_and_b32 v34, v7, v3
    v_and_b32 v35, v7, v4
    s_waitcnt vmcnt(6)
    buffer_load_dwordx4 v[64:67], v2, s[28:31], s44 offen offset:1024 nt
    v_mfma_f32_16x16x16_bf16 v[40:43], v[100:101], v[36:37], v[40:43]
    v_mfma_f32_16x16x16_bf16 v[44:47], v[102:103], v[36:37], v[44:47]
    v_fma_f32 v14, v14, s43, -v10
L_touch42:
    s_cbranch_execz L_touch43
    v_exp_f32 v14, v14
    s_nop 0
    v_cvt_pk_bf16_f32 v7, v14, v14
    v_add_f32 v6, v6, v14
    v_and_b32 v36, v7, v3
    v_and_b32 v37, v7, v4
    s_waitcnt vmcnt(6)
    buffer_load_dwordx4 v[68:71], v2, s[28:31], s44 offen offset:2048 nt
    v_mfma_f32_16x16x16_bf16 v[40:43], v[104:105], v[38:39], v[40:43]
    v_mfma_f32_16x16x16_bf16 v[44:47], v[106:107], v[38:39], v[44:47]
    v_fma_f32 v15, v15, s43, -v10
L_touch43:
    s_cbranch_execz L_touch44
    v_exp_f32 v15, v15
    s_nop 0
    v_cvt_pk_bf16_f32 v7, v15, v15
    v_add_f32 v6, v6, v15
    v_and_b32 v38, v7, v3
    v_and_b32 v39, v7, v4
    s_waitcnt vmcnt(6)
    buffer_load_dwordx4 v[72:75], v2, s[28:31], s44 offen offset:3072 nt
    s_xor_b32 s45, s44, 0xa000
    v_mfma_f32_16x16x16_bf16 v[40:43], v[108:109], v[32:33], v[40:43]
L_touch44:
    s_cbranch_execz L_touch45
    v_mfma_f32_16x16x16_bf16 v[44:47], v[110:111], v[32:33], v[44:47]
    s_waitcnt lgkmcnt(0)
    ds_read_b128 v[12:15], v56 offset:256
    v_add_u32 v56, 0x200, v56
    v_fma_f32 v28, v28, s43, -v10
    v_exp_f32 v28, v28
    s_nop 0
    v_cvt_pk_bf16_f32 v7, v28, v28
    v_add_f32 v6, v6, v28
    v_and_b32 v32, v7, v3
L_touch45:
    s_cbranch_execz L_touch46
    v_and_b32 v33, v7, v4
    s_waitcnt vmcnt(6)
    buffer_load_dwordx4 v[76:79], v2, s[28:31], s45 offen offset:0 nt
    v_mfma_f32_16x16x16_bf16 v[40:43], v[112:113], v[34:35], v[40:43]
    v_mfma_f32_16x16x16_bf16 v[44:47], v[114:115], v[34:35], v[44:47]
    v_fma_f32 v29, v29, s43, -v10
    v_exp_f32 v29, v29
    s_nop 0
    v_cvt_pk_bf16_f32 v7, v29, v29
    v_add_f32 v6, v6, v29
L_touch46:
    s_cbranch_execz L_touch47
    v_and_b32 v34, v7, v3
    v_and_b32 v35, v7, v4
    s_waitcnt vmcnt(6)
    buffer_load_dwordx4 v[80:83], v2, s[28:31], s45 offen offset:1024 nt
    v_mfma_f32_16x16x16_bf16 v[40:43], v[116:117], v[36:37], v[40:43]
    v_mfma_f32_16x16x16_bf16 v[44:47], v[118:119], v[36:37], v[44:47]
    v_fma_f32 v30, v30, s43, -v10
    v_exp_f32 v30, v30
    s_nop 0
    v_cvt_pk_bf16_f32 v7, v30, v30
L_touch47:
    s_cbranch_execz L_touch48
    v_add_f32 v6, v6, v30
    v_and_b32 v36, v7, v3
    v_and_b32 v37, v7, v4
    s_waitcnt lgkmcnt(0)
    v_fma_f32 v12, v12, s43, -v10
    v_exp_f32 v12, v12
    s_nop 0
    v_cvt_pk_bf16_f32 v7, v12, v12
    v_add_f32 v6, v6, v12
    v_and_b32 v124, v7, v3
    v_and_b32 v125, v7, v4
    v_fma_f32 v13, v13, s43, -v10
L_touch48:
    s_cbranch_execz L_touch49
    v_exp_f32 v13, v13
    s_nop 0
    v_cvt_pk_bf16_f32 v7, v13, v13
    v_add_f32 v6, v6, v13
    v_and_b32 v126, v7, v3
    v_and_b32 v127, v7, v4
    s_waitcnt vmcnt(6)
    buffer_load_dwordx4 v[84:87], v2, s[28:31], s45 offen offset:2048 nt
    buffer_load_dwordx4 v[88:91], v2, s[28:31], s45 offen offset:3072 nt
    v_mfma_f32_16x16x16_bf16 v[40:43], v[120:121], v[38:39], v[40:43]
    v_mfma_f32_16x16x16_bf16 v[44:47], v[122:123], v[38:39], v[44:47]
L_touch49:
    s_cbranch_execz L_touch50
    v_fma_f32 v31, v31, s43, -v10
    v_exp_f32 v31, v31
    s_nop 0
    v_cvt_pk_bf16_f32 v7, v31, v31
    v_add_f32 v6, v6, v31
    v_and_b32 v38, v7, v3
    v_and_b32 v39, v7, v4
    v_fma_f32 v14, v14, s43, -v10
    v_exp_f32 v14, v14
    s_nop 0
    v_cvt_pk_bf16_f32 v7, v14, v14
L_touch50:
    s_cbranch_execz L_touch51
    v_add_f32 v6, v6, v14
    v_and_b32 v128, v7, v3
    v_and_b32 v129, v7, v4
    v_fma_f32 v15, v15, s43, -v10
    v_exp_f32 v15, v15
    s_nop 0
    v_cvt_pk_bf16_f32 v7, v15, v15
    v_add_f32 v6, v6, v15
    v_and_b32 v130, v7, v3
    v_and_b32 v131, v7, v4
    v_mov_b32 v8, v6
    s_mov_b32 s32, s16
L_touch51:
    s_cbranch_execz L_touch52
    s_mov_b32 s33, s17
    v_permlane32_swap_b32 v6, v8
    v_add_f32 v6, v6, v8
    v_mov_b32 v8, v6
    s_lshl_b32 s47, s40, 10
    s_lshl_b32 s48, s42, 8
    v_permlane16_swap_b32 v6, v8
    v_add_f32 v9, v6, v8
    v_mov_b32 v8, v10
    ds_write_b64 v49, v[8:9] offset:12160
    s_add_u32 s47, s47, s48
    s_lshl_b32 s56, s47, 1
    s_lshl_b32 s59, s40, 7
    s_lshl3_add_u32 s59, s42, s59
L_touch52:
    s_cbranch_execz L_touch53
    s_add_u32 s59, s59, 0x40000
    v_mov_b32 v3, 0
    s_waitcnt lgkmcnt(0)
    s_barrier
    ds_read_b64 v[92:93], v51 offset:12160
    ds_read_b64 v[94:95], v51 offset:12288
    ds_read_b64 v[96:97], v51 offset:12416
    ds_read_b64 v[98:99], v51 offset:12544
    ds_read_b64 v[100:101], v51 offset:12672
L_touch53:
    s_cbranch_execz L_touch54
    ds_read_b32 v4, v3 offset:12800
    ds_read_b64 v[110:111], v50 offset:9728
    s_mov_b32 s28, s18
    s_mov_b32 s29, s19
    s_mov_b32 s30, 256
    v_lshlrev_b32 v1, 2, v11
    v_lshlrev_b32 v2, 3, v11
    v_lshlrev_b32 v53, 24, v11
    s_waitcnt lgkmcnt(0)
    v_readfirstlane_b32 s49, v4
    v_max3_f32 v22, v92, v94, v96
L_touch54:
    s_cbranch_execz L_touch55
    v_max3_f32 v22, v22, v98, v100
    v_sub_f32 v92, v92, v22
    v_sub_f32 v94, v94, v22
    v_sub_f32 v96, v96, v22
    v_sub_f32 v98, v98, v22
    v_sub_f32 v100, v100, v22
    v_exp_f32 v92, v92
    v_exp_f32 v94, v94
    v_exp_f32 v96, v96
    v_exp_f32 v98, v98
    v_exp_f32 v100, v100
    v_min_u32 v22, -2, v22
    v_mul_f32 v23, v92, v93
    v_fmac_f32 v23, v94, v95
L_touch55:
    s_cbranch_execz L_touch56
    v_fmac_f32 v23, v96, v97
    v_fmac_f32 v23, v98, v99
    v_fmac_f32 v23, v100, v101
    s_add_u32 s44, s59, 0x90000
    s_cmp_eq_u32 s49, 0
    s_cselect_b32 s44, s44, s59
    s_and_b32 s48, s49, 2
    s_lshl_b32 s48, s48, 5
    v_min_u32 v23, -2, v23
    s_add_u32 s48, s48, s44
    buffer_store_dwordx2 v[22:23], v53, s[36:39], s48 offen
    v_mul_f32 v20, v110, v100
    v_mul_f32 v21, v111, v100
L_touch56:
    s_cbranch_execz L_touch57
    s_waitcnt vmcnt(8)
    v_mfma_f32_16x16x16_bf16 v[40:43], v[60:61], v[32:33], v[40:43]
    v_mfma_f32_16x16x16_bf16 v[44:47], v[62:63], v[32:33], v[44:47]
    s_waitcnt vmcnt(7)
    v_mfma_f32_16x16x16_bf16 v[40:43], v[64:65], v[34:35], v[40:43]
    v_mfma_f32_16x16x16_bf16 v[44:47], v[66:67], v[34:35], v[44:47]
    s_waitcnt vmcnt(6)
    v_mfma_f32_16x16x16_bf16 v[40:43], v[68:69], v[36:37], v[40:43]
    v_mfma_f32_16x16x16_bf16 v[44:47], v[70:71], v[36:37], v[44:47]
L_touch57:
    s_cbranch_execz L_touch58
    s_waitcnt vmcnt(5)
    v_mfma_f32_16x16x16_bf16 v[40:43], v[72:73], v[38:39], v[40:43]
    v_mfma_f32_16x16x16_bf16 v[44:47], v[74:75], v[38:39], v[44:47]
    s_waitcnt vmcnt(4)
    v_mfma_f32_16x16x16_bf16 v[40:43], v[76:77], v[124:125], v[40:43]
    v_mfma_f32_16x16x16_bf16 v[44:47], v[78:79], v[124:125], v[44:47]
    s_waitcnt vmcnt(3)
    v_mfma_f32_16x16x16_bf16 v[40:43], v[80:81], v[126:127], v[40:43]
    v_mfma_f32_16x16x16_bf16 v[44:47], v[82:83], v[126:127], v[44:47]
L_touch58:
    s_cbranch_execz L_touch59
    s_waitcnt vmcnt(2)
    v_mfma_f32_16x16x16_bf16 v[40:43], v[84:85], v[128:129], v[40:43]
    v_mfma_f32_16x16x16_bf16 v[44:47], v[86:87], v[128:129], v[44:47]
    s_waitcnt vmcnt(1)
    buffer_load_dwordx2 v[24:25], off, s[36:39], s44 nt
    v_mfma_f32_16x16x16_bf16 v[40:43], v[88:89], v[130:131], v[40:43]
    v_mfma_f32_16x16x16_bf16 v[44:47], v[90:91], v[130:131], v[44:47]
    s_cmp_lt_u32 s49, 2
    s_nop 6
    ds_write2_b32 v48, v40, v44 offset0:0 offset1:4
L_touch59:
    s_cbranch_execz L_touch60
    ds_write2_b32 v48, v41, v45 offset0:8 offset1:12
    ds_write2_b32 v48, v42, v46 offset0:16 offset1:20
    ds_write2_b32 v48, v43, v47 offset0:24 offset1:28
    s_waitcnt lgkmcnt(0)
    s_barrier
    ds_read_b64 v[102:103], v50 offset:0
    ds_read_b64 v[104:105], v50 offset:2432
    ds_read_b64 v[106:107], v50 offset:4864
L_touch60:
    s_cbranch_execz L_touch61
    ds_read_b64 v[108:109], v50 offset:7296
    s_cbranch_scc0 L_take
    s_cmp_eq_u32 s49, 0
    s_waitcnt lgkmcnt(2)
    v_fmac_f32 v20, v102, v92
    v_fmac_f32 v21, v103, v92
    v_fmac_f32 v20, v104, v94
    v_fmac_f32 v21, v105, v94
    s_waitcnt lgkmcnt(0)
    v_fmac_f32 v20, v106, v96
    v_fmac_f32 v21, v107, v96
    v_fmac_f32 v20, v108, v98
    v_fmac_f32 v21, v109, v98
    v_min_u32 v20, -2, v20
L_touch61:
    s_cbranch_execz L_touch62
    v_min_u32 v21, -2, v21
    s_cbranch_scc1 L_give_far
    buffer_store_dwordx2 v[20:21], v2, s[36:39], s56 offen
    s_endpgm
L_take:
    buffer_load_dwordx2 v[112:113], v2, s[36:39], s56 offen nt
    s_waitcnt vmcnt(1)
    v_max_u32 v7, v24, v25
    v_cmp_eq_u32 vcc, -1, v7
    s_cbranch_vccnz L_slow
L_have_ml:
    v_max_f32 v7, v22, v24
    v_sub_f32 v22, v22, v7
    v_sub_f32 v24, v24, v7
    v_exp_f32 v22, v22
L_touch62:
    s_cbranch_execz L_touch63
    v_exp_f32 v24, v24
    s_mov_b32 s46, 0x400000
    v_mul_f32 v23, v23, v22
    v_fmac_f32 v23, v25, v24
    v_rcp_f32 v23, v23
    buffer_load_dwordx2 v[114:115], v2, s[36:39], s56 offen nt
    v_mul_f32 v22, v22, v23
    v_mul_f32 v24, v24, v23
    s_waitcnt lgkmcnt(2)
    v_fmac_f32 v20, v102, v92
    v_fmac_f32 v21, v103, v92
    v_fmac_f32 v20, v104, v94
    v_fmac_f32 v21, v105, v94
L_touch63:
    s_cbranch_execz L_touch64
    s_waitcnt lgkmcnt(0)
    v_fmac_f32 v20, v106, v96
    v_fmac_f32 v21, v107, v96
    v_fmac_f32 v20, v108, v98
    v_fmac_f32 v21, v109, v98
    buffer_load_dwordx2 v[116:117], v2, s[36:39], s56 offen nt
    v_mul_f32 v20, v20, v22
    v_mul_f32 v21, v21, v22
L_poll:
    s_waitcnt vmcnt(2)
    v_max_u32 v7, v112, v113
    v_cmp_eq_u32 vcc, -1, v7
    s_cbranch_vccz L_fin0
    buffer_load_dwordx2 v[112:113], v2, s[36:39], s56 offen nt
L_touch64:
    s_cbranch_execz L_touch65
    s_waitcnt vmcnt(2)
    v_max_u32 v7, v114, v115
    v_cmp_eq_u32 vcc, -1, v7
    s_cbranch_vccz L_fin1
    buffer_load_dwordx2 v[114:115], v2, s[36:39], s56 offen nt
    s_waitcnt vmcnt(2)
    v_max_u32 v7, v116, v117
    v_cmp_eq_u32 vcc, -1, v7
    s_cbranch_vccz L_fin2
    buffer_load_dwordx2 v[116:117], v2, s[36:39], s56 offen nt
    s_sub_u32 s46, s46, 1
    s_cbranch_scc0 L_poll
    s_waitcnt vmcnt(0)
L_fin0:
L_touch65:
    s_cbranch_execz L_touch66
    v_fmac_f32 v20, v112, v24
    v_fmac_f32 v21, v113, v24
    v_cvt_pk_bf16_f32 v20, v20, v21
    buffer_store_dword v20, v1, s[32:35], s47 offen
    s_endpgm
L_fin1:
    v_fmac_f32 v20, v114, v24
    v_fmac_f32 v21, v115, v24
    v_cvt_pk_bf16_f32 v20, v20, v21
    buffer_store_dword v20, v1, s[32:35], s47 offen
    s_endpgm
L_fin2:
    v_fmac_f32 v20, v116, v24
L_touch66:
    s_cbranch_execz L_touch67
    v_fmac_f32 v21, v117, v24
    v_cvt_pk_bf16_f32 v20, v20, v21
    buffer_store_dword v20, v1, s[32:35], s47 offen
    s_endpgm
L_slow:
    s_mov_b32 s46, 0x800000
L_slow_loop:
    buffer_load_dwordx2 v[24:25], off, s[36:39], s59 nt
    s_sub_u32 s46, s46, 1
    s_and_b32 s48, s46, 7
    s_waitcnt vmcnt(0)
    v_max_u32 v7, v24, v25
    v_cmp_eq_u32 vcc, -1, v7
L_touch67:
    s_cbranch_execz L_touch68
    s_cbranch_vccz L_slow_done
    s_cbranch_scc1 L_slow_loop
    buffer_load_ubyte v8, off, s[28:31], s40 offset:128 sc1
    s_cmp_eq_u32 s46, 0
    s_cbranch_scc1 L_far
    s_waitcnt vmcnt(0)
    v_cmp_eq_u32 vcc, 0, v8
    s_cbranch_vccnz L_slow_loop
L_far:
    s_add_u32 s56, s56, 0x80000
    s_add_u32 s59, s59, 0x80000
    buffer_load_dwordx2 v[24:25], off, s[36:39], s59 sc1
L_touch68:
    s_cbranch_execz L_touch69
    buffer_load_dwordx2 v[112:113], v2, s[36:39], s56 offen sc1
    s_waitcnt vmcnt(0)
    s_branch L_have_ml
L_slow_done:
    buffer_load_dwordx2 v[112:113], v2, s[36:39], s56 offen nt
    s_branch L_have_ml
L_touch69:
    s_cbranch_execz L_touch_done
L_end:
    s_endpgm
L_give_far:
    s_add_u32 s56, s56, 0x80000
    s_add_u32 s59, s59, 0x80000
    buffer_store_dwordx2 v[20:21], v2, s[36:39], s56 offen sc1
    buffer_store_dwordx2 v[22:23], v53, s[36:39], s59 offen sc1
    s_and_b32 s47, s40, 3
    s_lshl_b32 s47, s47, 3
    s_lshl_b32 s47, 1, s47
    v_mov_b32 v3, s47
    s_and_b32 s48, s40, 0x7c
    s_waitcnt vmcnt(0)
    s_barrier
    s_cmp_lg_u32 s42, 0
    s_cbranch_scc1 L_end
    s_mov_b64 exec, 1
    buffer_atomic_or v3, off, s[28:31], s48 offset:128 sc1
    s_endpgm
L_helper:
    v_lshrrev_b32 v8, 4, v11
    v_mul_u32_u24 v48, 608, v8
    v_bfe_u32 v9, v11, 2, 2
    v_mul_u32_u24 v9, 144, v9
    v_and_b32 v10, 3, v11
    v_lshlrev_b32 v10, 5, v10
    v_add3_u32 v48, v48, v9, v10
    v_lshlrev_b32 v49, 5, v8
    s_mov_b32 s55, 0x20000
    s_waitcnt lgkmcnt(0)
    s_mov_b32 s28, s18
    s_mov_b32 s29, s19
    s_mov_b32 s30, 256
    s_mov_b32 s31, 0x20000
    s_mov_b32 s36, s20
    s_mov_b32 s37, s21
    s_mov_b32 s38, 0x80000
    s_mov_b32 s39, 0x20000
    s_lshl_b32 s56, s40, 11
    s_lshl_b32 s59, s40, 7
    s_add_u32 s59, s59, 0x40000
    s_getreg_b32 s49, hwreg(HW_REG_XCC_ID, 0, 4)
    s_or_b32 s49, s49, 16
    s_cmp_eq_u32 s41, 0
    s_cbranch_scc1 L_skipclear
    v_lshlrev_b32 v7, 5, v11
    buffer_load_dword v8, v7, s[36:39], s56 offen
    buffer_load_dword v6, off, s[36:39], s59
    buffer_load_ubyte v4, off, s[28:31], s40
    v_and_b32 v7, 16, v2
    v_mov_b32 v28, -1
    v_mov_b32 v29, -1
    v_mov_b32 v30, -1
    v_mov_b32 v31, -1
    s_waitcnt vmcnt(0)
    buffer_store_dwordx4 v[28:31], v2, s[36:39], s56 offen offset:0
    buffer_store_dwordx4 v[28:31], v2, s[36:39], s56 offen offset:1024
    s_mov_b64 exec, 3
    buffer_store_dwordx4 v[28:31], v7, s[36:39], s59 offen
    s_mov_b64 exec, 1
    v_mov_b32 v3, s49
    s_waitcnt vmcnt(0)
    buffer_store_byte v3, off, s[28:31], s40
L_skipclear:
    s_mov_b64 exec, 0
    s_branch L_touch0
L_touch_done:
    s_mov_b64 exec, -1
    s_cmp_eq_u32 s41, 0
    s_cbranch_scc1 L_tree
    v_mov_b32 v28, 0
    v_mov_b32 v29, 0
    v_mov_b32 v30, 0
    v_mov_b32 v31, 0
    v_mov_b32 v32, 0
    v_mov_b32 v33, 0
    v_mov_b32 v34, 0
    v_mov_b32 v35, 0
    v_mov_b32 v36, 0xff800000
    v_mov_b32 v37, 0
    s_branch L_helper_put
L_tree:
    s_mov_b32 s32, s4
    s_mov_b32 s33, s5
    s_lshl_b32 s47, s40, 10
    buffer_load_dwordx4 v[12:15], v2, s[32:35], s47 offen
    v_and_b32 v7, 0xf0, v2
    s_mov_b32 s52, s10
    s_mov_b32 s53, s11
    s_mov_b32 s54, 0x8000
    s_lshl_b32 s47, s40, 8
    buffer_load_dwordx4 v[16:19], v7, s[52:55], s47 offen
    s_mov_b32 s52, s12
    s_mov_b32 s53, s13
    buffer_load_dwordx4 v[20:23], v7, s[52:55], s47 offen
    s_mov_b32 s52, s14
    s_mov_b32 s53, s15
    s_mov_b32 s54, 32
    s_lshr_b32 s47, s40, 3
    s_lshl_b32 s47, s47, 1
    buffer_load_ushort v24, off, s[52:55], s47
    v_mov_b32 v6, 0
    s_waitcnt vmcnt(0)
    v_lshlrev_b32 v7, 16, v12
    v_lshlrev_b32 v8, 16, v16
    v_fmac_f32 v6, v7, v8
    v_and_b32 v7, 0xffff0000, v12
    v_and_b32 v8, 0xffff0000, v16
    v_fmac_f32 v6, v7, v8
    v_lshlrev_b32 v7, 16, v13
    v_lshlrev_b32 v8, 16, v17
    v_fmac_f32 v6, v7, v8
    v_and_b32 v7, 0xffff0000, v13
    v_and_b32 v8, 0xffff0000, v17
    v_fmac_f32 v6, v7, v8
    v_lshlrev_b32 v7, 16, v14
    v_lshlrev_b32 v8, 16, v18
    v_fmac_f32 v6, v7, v8
    v_and_b32 v7, 0xffff0000, v14
    v_and_b32 v8, 0xffff0000, v18
    v_fmac_f32 v6, v7, v8
    v_lshlrev_b32 v7, 16, v15
    v_lshlrev_b32 v8, 16, v19
    v_fmac_f32 v6, v7, v8
    v_and_b32 v7, 0xffff0000, v15
    v_and_b32 v8, 0xffff0000, v19
    v_fmac_f32 v6, v7, v8
    s_nop 1
    v_add_f32_dpp v6, v6, v6 row_ror:8 row_mask:0xf bank_mask:0xf
    s_nop 1
    v_add_f32_dpp v6, v6, v6 row_ror:4 row_mask:0xf bank_mask:0xf
    s_nop 1
    v_add_f32_dpp v6, v6, v6 row_ror:2 row_mask:0xf bank_mask:0xf
    s_nop 1
    v_add_f32_dpp v6, v6, v6 row_ror:1 row_mask:0xf bank_mask:0xf
    v_lshlrev_b32 v24, 16, v24
    v_sub_f32 v24, 1.0, v24
    v_mul_f32 v24, 0xceabfb8f, v24
    v_mul_f32 v6, 0x3e0293ee, v6
    v_add_f32 v36, v6, v24
    v_mov_b32 v37, 1.0
    v_lshlrev_b32 v28, 16, v20
    v_and_b32 v29, 0xffff0000, v20
    v_lshlrev_b32 v30, 16, v21
    v_and_b32 v31, 0xffff0000, v21
    v_lshlrev_b32 v32, 16, v22
    v_and_b32 v33, 0xffff0000, v22
    v_lshlrev_b32 v34, 16, v23
    v_and_b32 v35, 0xffff0000, v23
L_helper_put:
    s_cmp_eq_u32 s41, 0
    ds_write_b128 v48, v[28:31] offset:9728
    ds_write_b128 v48, v[32:35] offset:9744
    ds_write_b64 v49, v[36:37] offset:12672
    v_mov_b32 v4, 2
    s_cbranch_scc0 L_seen
    s_mov_b32 s46, 8
    v_mov_b32 v4, 1
L_wait_hello:
    buffer_load_ubyte v8, off, s[28:31], s40 nt
    s_waitcnt vmcnt(0)
    v_readfirstlane_b32 s47, v8
    s_nop 1
    s_cmp_eq_u32 s47, s49
    s_cbranch_scc1 L_seen
    s_sleep 32
    s_sub_u32 s46, s46, 1
    s_cbranch_scc0 L_wait_hello
    v_mov_b32 v4, 0
L_seen:
    v_mov_b32 v7, 0
    ds_write_b32 v7, v4 offset:12800
    s_waitcnt lgkmcnt(0)
    s_endpgm
.section .rodata,"a"
.p2align 6
.amdhsa_kernel standalone__tree_speculative_verify_tree_attention_over_candidate_token_tree__sampling_kernel
  .amdhsa_next_free_vgpr 132
  .amdhsa_next_free_sgpr 60
  .amdhsa_accum_offset 132
  .amdhsa_group_segment_fixed_size 0
  .amdhsa_kernarg_size 72
  .amdhsa_user_sgpr_count 2
  .amdhsa_user_sgpr_kernarg_segment_ptr 1
  .amdhsa_system_sgpr_workgroup_id_x 1
.end_amdhsa_kernel
```
